```python
import torch

def _softmax(x, axis=-1):
    return torch.softmax(x, dim=axis)
def _gelu(x):
    return torch.nn.functional.gelu(x, approximate="tanh")
def _silu(x):
    return torch.nn.functional.silu(x)
def _sigmoid(x):
    return torch.sigmoid(x)
def _layernorm(x, axis=-1, eps=1e-5):
    m = x.mean(dim=axis, keepdim=True)
    v = x.var(dim=axis, keepdim=True, unbiased=False)
    return (x - m) / torch.sqrt(v + eps)
def _scatter_add(tgt, idx, src, axis=0):
    return tgt.clone().index_add_(axis, idx, src)
def _segment_sum(src, seg, n):
    out = torch.zeros((n,) + src.shape[1:], dtype=src.dtype)
    return out.index_add_(0, seg, src)
def _pad(x, pw):
    flat = tuple(v for pair in reversed(pw) for v in pair)
    return torch.nn.functional.pad(x, flat)

kernel_name = 'standalone__softmax_full_bidir__sampling'

def setup_inputs():

    _w = (lambda a: (lambda t: t.to(torch.bfloat16) if t.is_floating_point() else t)(torch.as_tensor(a)))
    B, H, Sq, Skv, Dh = 8, 32, 1, 4096, 128
    return {
        "q": _w((lambda *s: torch.randn(*s, dtype=torch.bfloat16) * 0.8)(B, H, Sq, Dh)),
        "k": _w((lambda *s: torch.randn(*s, dtype=torch.bfloat16) * 0.8)(B, H, Skv, Dh)),
        "v": _w((lambda *s: torch.randn(*s, dtype=torch.bfloat16) * 0.05)(B, H, Skv, Dh)),
    }

def reference(q, k, v):
    scale = q.shape[-1] ** -0.5
    scores = torch.einsum('bhqd,bhkd->bhqk', q, k) * scale
    attn = _softmax(scores, axis=-1)
    return torch.einsum('bhqk,bhkd->bhqd', attn, v)
```

```asm
; @launch grid=(256,1,1) block=(320,1,1) lds=82000
.amdgcn_target "amdgcn-amd-amdhsa--gfx950"
.text
.globl standalone__softmax_full_bidir__sampling_kernel
.p2align 8
.type standalone__softmax_full_bidir__sampling_kernel,@function
standalone__softmax_full_bidir__sampling_kernel:
    s_cmp_ge_u32 s2, 256
    s_cbranch_scc1 L_end
    s_load_dwordx8 s[4:11], s[0:1], 0
    v_lshrrev_b32 v3, 6, v0
    v_and_b32 v2, 15, v0
    v_readfirstlane_b32 s40, v3
    v_lshlrev_b32 v3, 4, v2
    s_cmp_eq_u32 s40, 4
    s_cbranch_scc1 L_helper
    v_bfe_u32 v4, v0, 4, 1
    v_lshl_add_u32 v1, v4, 11, v3
    v_bfe_u32 v4, v0, 5, 3
    v_lshl_add_u32 v1, v4, 13, v1
    s_mov_b32 s64, 0x1000
    s_mov_b32 s65, 0x10000
    s_mov_b32 s66, 0x11000
    s_lshl_b32 s20, s2, 20
    s_lshl_b32 s21, s2, 8
    s_mov_b32 s15, 0x20000
    s_mov_b32 s19, 0x20000
    s_mov_b32 s14, 0x100000
    s_mov_b32 s18, 0x100000
    s_mov_b32 s27, 0x20000
    s_mov_b32 s26, 256
    s_mov_b32 s51, 0x20000
    s_mov_b32 s50, 256
    s_waitcnt lgkmcnt(0)
    s_add_u32 s12, s6, s20
    s_addc_u32 s13, s7, 0
    buffer_load_dwordx4 v[40:43], v1, s[12:15], 0 offen nt
    buffer_load_dwordx4 v[44:47], v1, s[12:15], 0 offen offset:256 nt
    s_add_u32 s24, s4, s21
    s_addc_u32 s25, s5, 0
    s_add_u32 s16, s8, s20
    s_addc_u32 s17, s9, 0
    s_add_u32 s48, s10, s21
    s_addc_u32 s49, s11, 0
    buffer_load_dwordx4 v[4:7], v3, s[24:27], 0 offen
    buffer_load_dword v30, off, s[16:19], 0 nt
    buffer_load_dwordx4 v[48:51], v1, s[12:15], 0 offen offset:512 nt
    buffer_load_dwordx4 v[52:55], v1, s[12:15], 0 offen offset:768 nt
    buffer_load_dwordx4 v[56:59], v1, s[12:15], s64 offen nt
    buffer_load_dwordx4 v[60:63], v1, s[12:15], s64 offen offset:256 nt
    s_mov_b32 s44, s12
    s_mov_b32 s45, s13
    v_and_b32 v24, 1, v2
    v_lshlrev_b32 v24, 4, v24
    v_mov_b32 v26, 0xffff
    v_lshlrev_b32 v26, v24, v26
    v_lshrrev_b32 v24, 1, v2
    v_cmp_eq_u32 vcc, 0, v24
    s_nop 1
    v_cndmask_b32 v8, 0, v26, vcc
    v_cmp_eq_u32 vcc, 1, v24
    s_nop 1
    v_cndmask_b32 v9, 0, v26, vcc
    v_cmp_eq_u32 vcc, 2, v24
    s_nop 1
    v_cndmask_b32 v10, 0, v26, vcc
    v_cmp_eq_u32 vcc, 3, v24
    s_nop 1
    v_cndmask_b32 v11, 0, v26, vcc
    v_lshlrev_b32 v107, 5, v2
    v_and_b32 v24, 16, v0
    v_add_u32 v107, v107, v24
    s_lshl_b32 s41, s40, 9
    v_add_u32 v107, s41, v107
    s_mov_b32 s28, 0xcccccccc
    s_mov_b32 s29, 0xcccccccc
    s_mov_b32 s30, 0xaaaaaaaa
    s_mov_b32 s31, 0xaaaaaaaa
    v_mov_b32 v12, 0
    v_mov_b32 v13, 0
    v_mov_b32 v14, 0
    v_mov_b32 v15, 0
    v_mov_b32 v2, 0xff800000
    v_mov_b32 v3, 0
    v_mov_b32 v105, 0
    v_lshlrev_b32 v104, 2, v0
    s_lshl_b32 s41, s40, 4
    v_mov_b32 v106, s41
    v_mov_b32 v112, 0xffffffff
    v_mov_b32 v113, 0xffffffff
    v_mov_b32 v114, 0xaaaaaaaa
    v_mov_b32 v115, 0x0
    v_and_b32 v109, 63, v0
    v_lshlrev_b32 v109, 2, v109
    s_lshl_b32 s41, s40, 12
    v_add_u32 v109, s41, v109
    s_mov_b32 s3, 32
    s_waitcnt vmcnt(7)
    buffer_load_dwordx4 v[64:67], v1, s[12:15], s64 offen offset:512 nt
    s_waitcnt vmcnt(7)
    buffer_load_dwordx4 v[68:71], v1, s[12:15], s64 offen offset:768 nt
    s_waitcnt vmcnt(5)
    buffer_load_dwordx4 v[72:75], v1, s[12:15], s65 offen nt
    s_waitcnt vmcnt(5)
    buffer_load_dwordx4 v[76:79], v1, s[12:15], s65 offen offset:256 nt
    s_waitcnt vmcnt(5)
    buffer_load_dwordx4 v[80:83], v1, s[12:15], s65 offen offset:512 nt
    s_waitcnt vmcnt(5)
    buffer_load_dwordx4 v[84:87], v1, s[12:15], s65 offen offset:768 nt
    s_waitcnt vmcnt(5)
    buffer_load_dwordx4 v[88:91], v1, s[12:15], s66 offen nt
    s_waitcnt vmcnt(5)
    buffer_load_dwordx4 v[92:95], v1, s[12:15], s66 offen offset:256 nt
    s_waitcnt vmcnt(5)
    buffer_load_dwordx4 v[96:99], v1, s[12:15], s66 offen offset:512 nt
    s_waitcnt vmcnt(5)
    buffer_load_dwordx4 v[100:103], v1, s[12:15], s66 offen offset:768 nt
    s_barrier
L_kloop:
    s_sub_u32 s3, s3, 1
    s_cmp_lg_u32 s3, 16
    s_cselect_b32 s44, s44, s16
    s_cselect_b32 s45, s45, s17
    s_sub_u32 s46, 32, s3
    s_bfe_u32 s47, s46, 0x30000
    s_lshl_b32 s47, s47, 17
    s_bfe_u32 s54, s46, 0x10003
    s_lshl_b32 s54, s54, 10
    s_or_b32 s47, s47, s54
    s_add_u32 s12, s44, s47
    s_addc_u32 s13, s45, 0
    s_sub_u32 s14, 0x100000, s47
    s_waitcnt lgkmcnt(0)
    v_readfirstlane_b32 s32, v112
    v_readfirstlane_b32 s33, v113
    v_readfirstlane_b32 s34, v114
    v_readfirstlane_b32 s35, v115
    s_cmp_gt_u32 s3, 1
    s_cselect_b64 vcc, -1, 0
    s_cselect_b32 s32, s32, -1
    s_cselect_b32 s33, s33, -1
    s_cselect_b32 s34, s34, -1
    s_cselect_b32 s35, s35, -1
    s_waitcnt vmcnt(15)
    v_dot2_f32_bf16 v32, v40, v4, 0
    v_dot2_f32_bf16 v32, v41, v5, v32
    v_dot2_f32_bf16 v32, v42, v6, v32
    v_dot2_f32_bf16 v32, v43, v7, v32
    s_bitcmp1_b32 s34, 0
    s_cbranch_scc1 L_t1_3
    s_bitcmp1_b32 s32, 0
    s_cbranch_scc1 L_t1_1
    s_waitcnt vmcnt(2)
L_t1_1:
    s_bitcmp1_b32 s33, 0
    s_cbranch_scc1 L_t1_2
    s_waitcnt vmcnt(3)
L_t1_2:
    s_waitcnt vmcnt(4)
L_t1_3:
    s_bitcmp1_b32 s35, 0
    s_cbranch_scc1 L_t1_4
    s_waitcnt vmcnt(5)
L_t1_4:
    s_cbranch_vccz L_u1
    s_waitcnt vmcnt(6)
L_u1:
    buffer_load_dwordx4 v[40:43], v1, s[12:15], 0 offen nt
    s_waitcnt vmcnt(15)
    v_dot2_f32_bf16 v33, v44, v4, 0
    v_dot2_f32_bf16 v33, v45, v5, v33
    v_dot2_f32_bf16 v33, v46, v6, v33
    v_dot2_f32_bf16 v33, v47, v7, v33
    s_bitcmp1_b32 s34, 1
    s_cbranch_scc1 L_t2_3
    s_bitcmp1_b32 s32, 1
    s_cbranch_scc1 L_t2_1
    s_waitcnt vmcnt(2)
L_t2_1:
    s_bitcmp1_b32 s33, 1
    s_cbranch_scc1 L_t2_2
    s_waitcnt vmcnt(3)
L_t2_2:
    s_waitcnt vmcnt(4)
L_t2_3:
    s_bitcmp1_b32 s35, 1
    s_cbranch_scc1 L_t2_4
    s_waitcnt vmcnt(5)
L_t2_4:
    s_cbranch_vccz L_u2
    s_waitcnt vmcnt(6)
L_u2:
    buffer_load_dwordx4 v[44:47], v1, s[12:15], 0 offen offset:256 nt
    v_add_u32 v105, 1, v105
    ds_write_b32 v104, v105 offset:8192
    s_waitcnt vmcnt(15)
    v_dot2_f32_bf16 v34, v48, v4, 0
    v_dot2_f32_bf16 v34, v49, v5, v34
    v_dot2_f32_bf16 v34, v50, v6, v34
    v_dot2_f32_bf16 v34, v51, v7, v34
    v_add_f32_dpp v32, v32, v32 row_ror:8 row_mask:0xf bank_mask:0x3
    s_nop 1
    v_add_f32_dpp v32, v33, v33 row_ror:8 row_mask:0xf bank_mask:0xc
    s_bitcmp1_b32 s34, 2
    s_cbranch_scc1 L_t3_3
    s_bitcmp1_b32 s32, 2
    s_cbranch_scc1 L_t3_1
    s_waitcnt vmcnt(2)
L_t3_1:
    s_bitcmp1_b32 s33, 2
    s_cbranch_scc1 L_t3_2
    s_waitcnt vmcnt(3)
L_t3_2:
    s_waitcnt vmcnt(4)
L_t3_3:
    s_bitcmp1_b32 s35, 2
    s_cbranch_scc1 L_t3_4
    s_waitcnt vmcnt(5)
L_t3_4:
    s_cbranch_vccz L_u3
    s_waitcnt vmcnt(6)
L_u3:
    buffer_load_dwordx4 v[48:51], v1, s[12:15], 0 offen offset:512 nt
    s_waitcnt vmcnt(15)
    v_dot2_f32_bf16 v35, v52, v4, 0
    v_dot2_f32_bf16 v35, v53, v5, v35
    v_dot2_f32_bf16 v35, v54, v6, v35
    v_dot2_f32_bf16 v35, v55, v7, v35
    s_bitcmp1_b32 s34, 3
    s_cbranch_scc1 L_t4_3
    s_bitcmp1_b32 s32, 3
    s_cbranch_scc1 L_t4_1
    s_waitcnt vmcnt(2)
L_t4_1:
    s_bitcmp1_b32 s33, 3
    s_cbranch_scc1 L_t4_2
    s_waitcnt vmcnt(3)
L_t4_2:
    s_waitcnt vmcnt(4)
L_t4_3:
    s_bitcmp1_b32 s35, 3
    s_cbranch_scc1 L_t4_4
    s_waitcnt vmcnt(5)
L_t4_4:
    s_cbranch_vccz L_u4
    s_waitcnt vmcnt(6)
L_u4:
    buffer_load_dwordx4 v[52:55], v1, s[12:15], 0 offen offset:768 nt
    v_add_u32 v105, 1, v105
    ds_write_b32 v104, v105 offset:8192
    s_waitcnt vmcnt(15)
    v_dot2_f32_bf16 v36, v56, v4, 0
    v_dot2_f32_bf16 v36, v57, v5, v36
    v_dot2_f32_bf16 v36, v58, v6, v36
    v_dot2_f32_bf16 v36, v59, v7, v36
    v_add_f32_dpp v34, v34, v34 row_ror:8 row_mask:0xf bank_mask:0x3
    s_nop 1
    v_add_f32_dpp v34, v35, v35 row_ror:8 row_mask:0xf bank_mask:0xc
    v_add_f32_dpp v32, v32, v32 row_half_mirror row_mask:0xf bank_mask:0x5
    s_nop 1
    v_add_f32_dpp v32, v34, v34 row_half_mirror row_mask:0xf bank_mask:0xa
    s_bitcmp1_b32 s34, 4
    s_cbranch_scc1 L_t5_3
    s_bitcmp1_b32 s32, 4
    s_cbranch_scc1 L_t5_1
    s_waitcnt vmcnt(2)
L_t5_1:
    s_bitcmp1_b32 s33, 4
    s_cbranch_scc1 L_t5_2
    s_waitcnt vmcnt(3)
L_t5_2:
    s_waitcnt vmcnt(4)
L_t5_3:
    s_bitcmp1_b32 s35, 4
    s_cbranch_scc1 L_t5_4
    s_waitcnt vmcnt(5)
L_t5_4:
    s_cbranch_vccz L_u5
    s_waitcnt vmcnt(6)
L_u5:
    buffer_load_dwordx4 v[56:59], v1, s[12:15], s64 offen nt
    s_waitcnt vmcnt(15)
    v_dot2_f32_bf16 v37, v60, v4, 0
    v_dot2_f32_bf16 v37, v61, v5, v37
    v_dot2_f32_bf16 v37, v62, v6, v37
    v_dot2_f32_bf16 v37, v63, v7, v37
    s_bitcmp1_b32 s34, 5
    s_cbranch_scc1 L_t6_3
    s_bitcmp1_b32 s32, 5
    s_cbranch_scc1 L_t6_1
    s_waitcnt vmcnt(2)
L_t6_1:
    s_bitcmp1_b32 s33, 5
    s_cbranch_scc1 L_t6_2
    s_waitcnt vmcnt(3)
L_t6_2:
    s_waitcnt vmcnt(4)
L_t6_3:
    s_bitcmp1_b32 s35, 5
    s_cbranch_scc1 L_t6_4
    s_waitcnt vmcnt(5)
L_t6_4:
    s_cbranch_vccz L_u6
    s_waitcnt vmcnt(6)
L_u6:
    buffer_load_dwordx4 v[60:63], v1, s[12:15], s64 offen offset:256 nt
    v_add_u32 v105, 1, v105
    ds_write_b32 v104, v105 offset:8192
    s_waitcnt vmcnt(15)
    v_dot2_f32_bf16 v38, v64, v4, 0
    v_dot2_f32_bf16 v38, v65, v5, v38
    v_dot2_f32_bf16 v38, v66, v6, v38
    v_dot2_f32_bf16 v38, v67, v7, v38
    v_add_f32_dpp v36, v36, v36 row_ror:8 row_mask:0xf bank_mask:0x3
    s_nop 1
    v_add_f32_dpp v36, v37, v37 row_ror:8 row_mask:0xf bank_mask:0xc
    s_bitcmp1_b32 s34, 6
    s_cbranch_scc1 L_t7_3
    s_bitcmp1_b32 s32, 6
    s_cbranch_scc1 L_t7_1
    s_waitcnt vmcnt(2)
L_t7_1:
    s_bitcmp1_b32 s33, 6
    s_cbranch_scc1 L_t7_2
    s_waitcnt vmcnt(3)
L_t7_2:
    s_waitcnt vmcnt(4)
L_t7_3:
    s_bitcmp1_b32 s35, 6
    s_cbranch_scc1 L_t7_4
    s_waitcnt vmcnt(5)
L_t7_4:
    s_cbranch_vccz L_u7
    s_waitcnt vmcnt(6)
L_u7:
    buffer_load_dwordx4 v[64:67], v1, s[12:15], s64 offen offset:512 nt
    s_waitcnt vmcnt(15)
    v_dot2_f32_bf16 v39, v68, v4, 0
    v_dot2_f32_bf16 v39, v69, v5, v39
    v_dot2_f32_bf16 v39, v70, v6, v39
    v_dot2_f32_bf16 v39, v71, v7, v39
    s_bitcmp1_b32 s34, 7
    s_cbranch_scc1 L_t8_3
    s_bitcmp1_b32 s32, 7
    s_cbranch_scc1 L_t8_1
    s_waitcnt vmcnt(2)
L_t8_1:
    s_bitcmp1_b32 s33, 7
    s_cbranch_scc1 L_t8_2
    s_waitcnt vmcnt(3)
L_t8_2:
    s_waitcnt vmcnt(4)
L_t8_3:
    s_bitcmp1_b32 s35, 7
    s_cbranch_scc1 L_t8_4
    s_waitcnt vmcnt(5)
L_t8_4:
    s_cbranch_vccz L_u8
    s_waitcnt vmcnt(6)
L_u8:
    buffer_load_dwordx4 v[68:71], v1, s[12:15], s64 offen offset:768 nt
    v_add_u32 v105, 1, v105
    ds_write_b32 v104, v105 offset:8192
    s_waitcnt vmcnt(15)
    v_dot2_f32_bf16 v33, v72, v4, 0
    v_dot2_f32_bf16 v33, v73, v5, v33
    v_dot2_f32_bf16 v33, v74, v6, v33
    v_dot2_f32_bf16 v33, v75, v7, v33
    v_add_f32_dpp v38, v38, v38 row_ror:8 row_mask:0xf bank_mask:0x3
    s_nop 1
    v_add_f32_dpp v38, v39, v39 row_ror:8 row_mask:0xf bank_mask:0xc
    v_add_f32_dpp v36, v36, v36 row_half_mirror row_mask:0xf bank_mask:0x5
    s_nop 1
    v_add_f32_dpp v36, v38, v38 row_half_mirror row_mask:0xf bank_mask:0xa
    v_add_f32_dpp v32, v32, v32 quad_perm:[2,3,0,1] row_mask:0xf bank_mask:0xf
    s_nop 0
    v_add_f32_dpp v36, v36, v36 quad_perm:[2,3,0,1] row_mask:0xf bank_mask:0xf
    v_cndmask_b32 v32, v32, v36, s[28:29]
    s_bitcmp1_b32 s34, 8
    s_cbranch_scc1 L_t9_3
    s_bitcmp1_b32 s32, 8
    s_cbranch_scc1 L_t9_1
    s_waitcnt vmcnt(2)
L_t9_1:
    s_bitcmp1_b32 s33, 8
    s_cbranch_scc1 L_t9_2
    s_waitcnt vmcnt(3)
L_t9_2:
    s_waitcnt vmcnt(4)
L_t9_3:
    s_bitcmp1_b32 s35, 8
    s_cbranch_scc1 L_t9_4
    s_waitcnt vmcnt(5)
L_t9_4:
    s_cbranch_vccz L_u9
    s_waitcnt vmcnt(6)
L_u9:
    buffer_load_dwordx4 v[72:75], v1, s[12:15], s65 offen nt
    s_waitcnt vmcnt(15)
    v_dot2_f32_bf16 v35, v76, v4, 0
    v_dot2_f32_bf16 v35, v77, v5, v35
    v_dot2_f32_bf16 v35, v78, v6, v35
    v_dot2_f32_bf16 v35, v79, v7, v35
    s_bitcmp1_b32 s34, 9
    s_cbranch_scc1 L_t10_3
    s_bitcmp1_b32 s32, 9
    s_cbranch_scc1 L_t10_1
    s_waitcnt vmcnt(2)
L_t10_1:
    s_bitcmp1_b32 s33, 9
    s_cbranch_scc1 L_t10_2
    s_waitcnt vmcnt(3)
L_t10_2:
    s_waitcnt vmcnt(4)
L_t10_3:
    s_bitcmp1_b32 s35, 9
    s_cbranch_scc1 L_t10_4
    s_waitcnt vmcnt(5)
L_t10_4:
    s_cbranch_vccz L_u10
    s_waitcnt vmcnt(6)
L_u10:
    buffer_load_dwordx4 v[76:79], v1, s[12:15], s65 offen offset:256 nt
    v_add_u32 v105, 1, v105
    ds_write_b32 v104, v105 offset:8192
    s_waitcnt vmcnt(15)
    v_dot2_f32_bf16 v34, v80, v4, 0
    v_dot2_f32_bf16 v34, v81, v5, v34
    v_dot2_f32_bf16 v34, v82, v6, v34
    v_dot2_f32_bf16 v34, v83, v7, v34
    v_add_f32_dpp v33, v33, v33 row_ror:8 row_mask:0xf bank_mask:0x3
    s_nop 1
    v_add_f32_dpp v33, v35, v35 row_ror:8 row_mask:0xf bank_mask:0xc
    s_bitcmp1_b32 s34, 10
    s_cbranch_scc1 L_t11_3
    s_bitcmp1_b32 s32, 10
    s_cbranch_scc1 L_t11_1
    s_waitcnt vmcnt(2)
L_t11_1:
    s_bitcmp1_b32 s33, 10
    s_cbranch_scc1 L_t11_2
    s_waitcnt vmcnt(3)
L_t11_2:
    s_waitcnt vmcnt(4)
L_t11_3:
    s_bitcmp1_b32 s35, 10
    s_cbranch_scc1 L_t11_4
    s_waitcnt vmcnt(5)
L_t11_4:
    s_cbranch_vccz L_u11
    s_waitcnt vmcnt(6)
L_u11:
    buffer_load_dwordx4 v[80:83], v1, s[12:15], s65 offen offset:512 nt
    s_waitcnt vmcnt(15)
    v_dot2_f32_bf16 v37, v84, v4, 0
    v_dot2_f32_bf16 v37, v85, v5, v37
    v_dot2_f32_bf16 v37, v86, v6, v37
    v_dot2_f32_bf16 v37, v87, v7, v37
    s_bitcmp1_b32 s34, 11
    s_cbranch_scc1 L_t12_3
    s_bitcmp1_b32 s32, 11
    s_cbranch_scc1 L_t12_1
    s_waitcnt vmcnt(2)
L_t12_1:
    s_bitcmp1_b32 s33, 11
    s_cbranch_scc1 L_t12_2
    s_waitcnt vmcnt(3)
L_t12_2:
    s_waitcnt vmcnt(4)
L_t12_3:
    s_bitcmp1_b32 s35, 11
    s_cbranch_scc1 L_t12_4
    s_waitcnt vmcnt(5)
L_t12_4:
    s_cbranch_vccz L_u12
    s_waitcnt vmcnt(6)
L_u12:
    buffer_load_dwordx4 v[84:87], v1, s[12:15], s65 offen offset:768 nt
    v_add_u32 v105, 1, v105
    ds_write_b32 v104, v105 offset:8192
    s_waitcnt vmcnt(15)
    v_dot2_f32_bf16 v39, v88, v4, 0
    v_dot2_f32_bf16 v39, v89, v5, v39
    v_dot2_f32_bf16 v39, v90, v6, v39
    v_dot2_f32_bf16 v39, v91, v7, v39
    v_add_f32_dpp v34, v34, v34 row_ror:8 row_mask:0xf bank_mask:0x3
    s_nop 1
    v_add_f32_dpp v34, v37, v37 row_ror:8 row_mask:0xf bank_mask:0xc
    v_add_f32_dpp v33, v33, v33 row_half_mirror row_mask:0xf bank_mask:0x5
    s_nop 1
    v_add_f32_dpp v33, v34, v34 row_half_mirror row_mask:0xf bank_mask:0xa
    s_bitcmp1_b32 s34, 12
    s_cbranch_scc1 L_t13_3
    s_bitcmp1_b32 s32, 12
    s_cbranch_scc1 L_t13_1
    s_waitcnt vmcnt(2)
L_t13_1:
    s_bitcmp1_b32 s33, 12
    s_cbranch_scc1 L_t13_2
    s_waitcnt vmcnt(3)
L_t13_2:
    s_waitcnt vmcnt(4)
L_t13_3:
    s_bitcmp1_b32 s35, 12
    s_cbranch_scc1 L_t13_4
    s_waitcnt vmcnt(5)
L_t13_4:
    s_cbranch_vccz L_u13
    s_waitcnt vmcnt(6)
L_u13:
    buffer_load_dwordx4 v[88:91], v1, s[12:15], s66 offen nt
    s_waitcnt vmcnt(15)
    v_dot2_f32_bf16 v38, v92, v4, 0
    v_dot2_f32_bf16 v38, v93, v5, v38
    v_dot2_f32_bf16 v38, v94, v6, v38
    v_dot2_f32_bf16 v38, v95, v7, v38
    s_bitcmp1_b32 s34, 13
    s_cbranch_scc1 L_t14_3
    s_bitcmp1_b32 s32, 13
    s_cbranch_scc1 L_t14_1
    s_waitcnt vmcnt(2)
L_t14_1:
    s_bitcmp1_b32 s33, 13
    s_cbranch_scc1 L_t14_2
    s_waitcnt vmcnt(3)
L_t14_2:
    s_waitcnt vmcnt(4)
L_t14_3:
    s_bitcmp1_b32 s35, 13
    s_cbranch_scc1 L_t14_4
    s_waitcnt vmcnt(5)
L_t14_4:
    s_cbranch_vccz L_u14
    s_waitcnt vmcnt(6)
L_u14:
    buffer_load_dwordx4 v[92:95], v1, s[12:15], s66 offen offset:256 nt
    v_add_u32 v105, 1, v105
    ds_write_b32 v104, v105 offset:8192
    s_waitcnt vmcnt(15)
    v_dot2_f32_bf16 v36, v96, v4, 0
    v_dot2_f32_bf16 v36, v97, v5, v36
    v_dot2_f32_bf16 v36, v98, v6, v36
    v_dot2_f32_bf16 v36, v99, v7, v36
    v_add_f32_dpp v39, v39, v39 row_ror:8 row_mask:0xf bank_mask:0x3
    s_nop 1
    v_add_f32_dpp v39, v38, v38 row_ror:8 row_mask:0xf bank_mask:0xc
    s_bitcmp1_b32 s34, 14
    s_cbranch_scc1 L_t15_3
    s_bitcmp1_b32 s32, 14
    s_cbranch_scc1 L_t15_1
    s_waitcnt vmcnt(2)
L_t15_1:
    s_bitcmp1_b32 s33, 14
    s_cbranch_scc1 L_t15_2
    s_waitcnt vmcnt(3)
L_t15_2:
    s_waitcnt vmcnt(4)
L_t15_3:
    s_bitcmp1_b32 s35, 14
    s_cbranch_scc1 L_t15_4
    s_waitcnt vmcnt(5)
L_t15_4:
    s_cbranch_vccz L_u15
    s_waitcnt vmcnt(6)
L_u15:
    buffer_load_dwordx4 v[96:99], v1, s[12:15], s66 offen offset:512 nt
    s_waitcnt vmcnt(15)
    v_dot2_f32_bf16 v35, v100, v4, 0
    v_dot2_f32_bf16 v35, v101, v5, v35
    v_dot2_f32_bf16 v35, v102, v6, v35
    v_dot2_f32_bf16 v35, v103, v7, v35
    s_bitcmp1_b32 s34, 15
    s_cbranch_scc1 L_t16_3
    s_bitcmp1_b32 s32, 15
    s_cbranch_scc1 L_t16_1
    s_waitcnt vmcnt(2)
L_t16_1:
    s_bitcmp1_b32 s33, 15
    s_cbranch_scc1 L_t16_2
    s_waitcnt vmcnt(3)
L_t16_2:
    s_waitcnt vmcnt(4)
L_t16_3:
    s_bitcmp1_b32 s35, 15
    s_cbranch_scc1 L_t16_4
    s_waitcnt vmcnt(5)
L_t16_4:
    s_cbranch_vccz L_u16
    s_waitcnt vmcnt(6)
L_u16:
    buffer_load_dwordx4 v[100:103], v1, s[12:15], s66 offen offset:768 nt
    v_add_u32 v105, 1, v105
    ds_write_b32 v104, v105 offset:8192
    ds_read_b128 v[112:115], v106 offset:9216
    v_add_f32_dpp v36, v36, v36 row_ror:8 row_mask:0xf bank_mask:0x3
    s_nop 1
    v_add_f32_dpp v36, v35, v35 row_ror:8 row_mask:0xf bank_mask:0xc
    v_add_f32_dpp v39, v39, v39 row_half_mirror row_mask:0xf bank_mask:0x5
    s_nop 1
    v_add_f32_dpp v39, v36, v36 row_half_mirror row_mask:0xf bank_mask:0xa
    v_add_f32_dpp v33, v33, v33 quad_perm:[2,3,0,1] row_mask:0xf bank_mask:0xf
    s_nop 0
    v_add_f32_dpp v39, v39, v39 quad_perm:[2,3,0,1] row_mask:0xf bank_mask:0xf
    v_cndmask_b32 v33, v33, v39, s[28:29]
    v_add_f32_dpp v32, v32, v32 quad_perm:[1,0,3,2] row_mask:0xf bank_mask:0xf
    s_nop 0
    v_add_f32_dpp v33, v33, v33 quad_perm:[1,0,3,2] row_mask:0xf bank_mask:0xf
    v_cndmask_b32 v32, v32, v33, s[30:31]
    v_mul_f32 v24, 0x3e0293ee, v32
    ds_write_b32 v109, v24 offset:12288
    v_max_f32 v2, v2, v24
    v_add_u32 v109, 0x100, v109
    s_cmp_lg_u32 s3, 16
    s_cbranch_scc1 L_kloop
    v_subrev_u32 v109, 0x1000, v109
    ds_read_b32 v27, v109 offset:12288
    v_max_f32_dpp v2, v2, v2 row_ror:8 row_mask:0xf bank_mask:0xf
    s_nop 1
    v_max_f32_dpp v2, v2, v2 row_ror:4 row_mask:0xf bank_mask:0xf
    s_nop 1
    v_max_f32_dpp v2, v2, v2 row_ror:2 row_mask:0xf bank_mask:0xf
    s_nop 1
    v_max_f32_dpp v2, v2, v2 row_ror:1 row_mask:0xf bank_mask:0xf
    v_mov_b32 v26, v2
    s_nop 1
    v_permlane32_swap_b32 v26, v2
    v_max_f32 v2, v26, v2
    v_mov_b32 v26, v2
    s_nop 1
    v_permlane16_swap_b32 v26, v2
    v_max_f32 v2, v26, v2
L_vloop:
    s_sub_u32 s3, s3, 1
    s_sub_u32 s46, 32, s3
    s_bfe_u32 s47, s46, 0x30000
    s_lshl_b32 s47, s47, 17
    s_bfe_u32 s54, s46, 0x10003
    s_lshl_b32 s54, s54, 10
    s_or_b32 s47, s47, s54
    s_add_u32 s12, s16, s47
    s_addc_u32 s13, s17, 0
    s_sub_u32 s14, 0x100000, s47
    s_cmp_eq_u32 s3, 0
    s_cselect_b32 s14, 0, s14
    v_add_u32 v109, 0x100, v109
    s_waitcnt lgkmcnt(0)
    v_readfirstlane_b32 s32, v112
    v_readfirstlane_b32 s33, v113
    v_readfirstlane_b32 s34, v114
    v_readfirstlane_b32 s35, v115
    s_cmp_gt_u32 s3, 1
    s_cselect_b64 vcc, -1, 0
    s_cselect_b32 s32, s32, -1
    s_cselect_b32 s33, s33, -1
    s_cselect_b32 s34, s34, -1
    s_cselect_b32 s35, s35, -1
    v_sub_f32 v24, v27, v2
    ds_read_b32 v27, v109 offset:12288
    v_exp_f32 v24, v24
    s_nop 0
    v_cvt_pk_bf16_f32 v28, v24, v24
    v_add_f32 v3, v3, v24
    s_nop 0
    v_and_b32_dpp v16, v28, v8 row_newbcast:0 row_mask:0xf bank_mask:0xf
    v_and_b32_dpp v17, v28, v9 row_newbcast:0 row_mask:0xf bank_mask:0xf
    v_and_b32_dpp v18, v28, v10 row_newbcast:0 row_mask:0xf bank_mask:0xf
    v_and_b32_dpp v19, v28, v11 row_newbcast:0 row_mask:0xf bank_mask:0xf
    s_cmp_lg_u32 s3, 0
    s_cbranch_scc1 L_notlast
    v_add_f32_dpp v3, v3, v3 row_ror:8 row_mask:0xf bank_mask:0xf
    s_nop 1
    v_add_f32_dpp v3, v3, v3 row_ror:4 row_mask:0xf bank_mask:0xf
    s_nop 1
    v_add_f32_dpp v3, v3, v3 row_ror:2 row_mask:0xf bank_mask:0xf
    s_nop 1
    v_add_f32_dpp v3, v3, v3 row_ror:1 row_mask:0xf bank_mask:0xf
    v_mov_b32 v26, v3
    s_nop 1
    v_permlane32_swap_b32 v26, v3
    v_add_f32 v3, v26, v3
    v_mov_b32 v26, v3
    s_nop 1
    v_permlane16_swap_b32 v26, v3
    v_add_f32 v3, v26, v3
    v_lshrrev_b32 v26, 1, v106
    ds_write_b64 v26, v[2:3] offset:2048
L_notlast:
    v_and_b32_dpp v20, v28, v8 row_newbcast:8 row_mask:0xf bank_mask:0xf
    v_and_b32_dpp v21, v28, v9 row_newbcast:8 row_mask:0xf bank_mask:0xf
    v_and_b32_dpp v22, v28, v10 row_newbcast:8 row_mask:0xf bank_mask:0xf
    v_and_b32_dpp v23, v28, v11 row_newbcast:8 row_mask:0xf bank_mask:0xf
    s_waitcnt vmcnt(15)
    v_mfma_f32_16x16x32_bf16 v[12:15], v[16:19], v[40:43], v[12:15]
    s_bitcmp1_b32 s34, 16
    s_cbranch_scc1 L_t17_3
    s_bitcmp1_b32 s32, 16
    s_cbranch_scc1 L_t17_1
    s_waitcnt vmcnt(2)
L_t17_1:
    s_bitcmp1_b32 s33, 16
    s_cbranch_scc1 L_t17_2
    s_waitcnt vmcnt(3)
L_t17_2:
    s_waitcnt vmcnt(4)
L_t17_3:
    s_bitcmp1_b32 s35, 16
    s_cbranch_scc1 L_t17_4
    s_waitcnt vmcnt(5)
L_t17_4:
    s_cbranch_vccz L_u17
    s_waitcnt vmcnt(6)
L_u17:
    buffer_load_dwordx4 v[40:43], v1, s[12:15], 0 offen nt
    v_and_b32_dpp v16, v28, v8 row_newbcast:4 row_mask:0xf bank_mask:0xf
    v_and_b32_dpp v17, v28, v9 row_newbcast:4 row_mask:0xf bank_mask:0xf
    v_and_b32_dpp v18, v28, v10 row_newbcast:4 row_mask:0xf bank_mask:0xf
    v_and_b32_dpp v19, v28, v11 row_newbcast:4 row_mask:0xf bank_mask:0xf
    s_waitcnt vmcnt(15)
    v_mfma_f32_16x16x32_bf16 v[12:15], v[20:23], v[44:47], v[12:15]
    s_bitcmp1_b32 s34, 17
    s_cbranch_scc1 L_t18_3
    s_bitcmp1_b32 s32, 17
    s_cbranch_scc1 L_t18_1
    s_waitcnt vmcnt(2)
L_t18_1:
    s_bitcmp1_b32 s33, 17
    s_cbranch_scc1 L_t18_2
    s_waitcnt vmcnt(3)
L_t18_2:
    s_waitcnt vmcnt(4)
L_t18_3:
    s_bitcmp1_b32 s35, 17
    s_cbranch_scc1 L_t18_4
    s_waitcnt vmcnt(5)
L_t18_4:
    s_cbranch_vccz L_u18
    s_waitcnt vmcnt(6)
L_u18:
    buffer_load_dwordx4 v[44:47], v1, s[12:15], 0 offen offset:256 nt
    v_add_u32 v105, 1, v105
    ds_write_b32 v104, v105 offset:8192
    v_and_b32_dpp v20, v28, v8 row_newbcast:12 row_mask:0xf bank_mask:0xf
    v_and_b32_dpp v21, v28, v9 row_newbcast:12 row_mask:0xf bank_mask:0xf
    v_and_b32_dpp v22, v28, v10 row_newbcast:12 row_mask:0xf bank_mask:0xf
    v_and_b32_dpp v23, v28, v11 row_newbcast:12 row_mask:0xf bank_mask:0xf
    s_waitcnt vmcnt(15)
    v_mfma_f32_16x16x32_bf16 v[12:15], v[16:19], v[48:51], v[12:15]
    s_bitcmp1_b32 s34, 18
    s_cbranch_scc1 L_t19_3
    s_bitcmp1_b32 s32, 18
    s_cbranch_scc1 L_t19_1
    s_waitcnt vmcnt(2)
L_t19_1:
    s_bitcmp1_b32 s33, 18
    s_cbranch_scc1 L_t19_2
    s_waitcnt vmcnt(3)
L_t19_2:
    s_waitcnt vmcnt(4)
L_t19_3:
    s_bitcmp1_b32 s35, 18
    s_cbranch_scc1 L_t19_4
    s_waitcnt vmcnt(5)
L_t19_4:
    s_cbranch_vccz L_u19
    s_waitcnt vmcnt(6)
L_u19:
    buffer_load_dwordx4 v[48:51], v1, s[12:15], 0 offen offset:512 nt
    v_and_b32_dpp v16, v28, v8 row_newbcast:2 row_mask:0xf bank_mask:0xf
    v_and_b32_dpp v17, v28, v9 row_newbcast:2 row_mask:0xf bank_mask:0xf
    v_and_b32_dpp v18, v28, v10 row_newbcast:2 row_mask:0xf bank_mask:0xf
    v_and_b32_dpp v19, v28, v11 row_newbcast:2 row_mask:0xf bank_mask:0xf
    s_waitcnt vmcnt(15)
    v_mfma_f32_16x16x32_bf16 v[12:15], v[20:23], v[52:55], v[12:15]
    s_bitcmp1_b32 s34, 19
    s_cbranch_scc1 L_t20_3
    s_bitcmp1_b32 s32, 19
    s_cbranch_scc1 L_t20_1
    s_waitcnt vmcnt(2)
L_t20_1:
    s_bitcmp1_b32 s33, 19
    s_cbranch_scc1 L_t20_2
    s_waitcnt vmcnt(3)
L_t20_2:
    s_waitcnt vmcnt(4)
L_t20_3:
    s_bitcmp1_b32 s35, 19
    s_cbranch_scc1 L_t20_4
    s_waitcnt vmcnt(5)
L_t20_4:
    s_cbranch_vccz L_u20
    s_waitcnt vmcnt(6)
L_u20:
    buffer_load_dwordx4 v[52:55], v1, s[12:15], 0 offen offset:768 nt
    v_add_u32 v105, 1, v105
    ds_write_b32 v104, v105 offset:8192
    v_and_b32_dpp v20, v28, v8 row_newbcast:10 row_mask:0xf bank_mask:0xf
    v_and_b32_dpp v21, v28, v9 row_newbcast:10 row_mask:0xf bank_mask:0xf
    v_and_b32_dpp v22, v28, v10 row_newbcast:10 row_mask:0xf bank_mask:0xf
    v_and_b32_dpp v23, v28, v11 row_newbcast:10 row_mask:0xf bank_mask:0xf
    s_waitcnt vmcnt(15)
    v_mfma_f32_16x16x32_bf16 v[12:15], v[16:19], v[56:59], v[12:15]
    s_bitcmp1_b32 s34, 20
    s_cbranch_scc1 L_t21_3
    s_bitcmp1_b32 s32, 20
    s_cbranch_scc1 L_t21_1
    s_waitcnt vmcnt(2)
L_t21_1:
    s_bitcmp1_b32 s33, 20
    s_cbranch_scc1 L_t21_2
    s_waitcnt vmcnt(3)
L_t21_2:
    s_waitcnt vmcnt(4)
L_t21_3:
    s_bitcmp1_b32 s35, 20
    s_cbranch_scc1 L_t21_4
    s_waitcnt vmcnt(5)
L_t21_4:
    s_cbranch_vccz L_u21
    s_waitcnt vmcnt(6)
L_u21:
    buffer_load_dwordx4 v[56:59], v1, s[12:15], s64 offen nt
    v_and_b32_dpp v16, v28, v8 row_newbcast:6 row_mask:0xf bank_mask:0xf
    v_and_b32_dpp v17, v28, v9 row_newbcast:6 row_mask:0xf bank_mask:0xf
    v_and_b32_dpp v18, v28, v10 row_newbcast:6 row_mask:0xf bank_mask:0xf
    v_and_b32_dpp v19, v28, v11 row_newbcast:6 row_mask:0xf bank_mask:0xf
    s_waitcnt vmcnt(15)
    v_mfma_f32_16x16x32_bf16 v[12:15], v[20:23], v[60:63], v[12:15]
    s_bitcmp1_b32 s34, 21
    s_cbranch_scc1 L_t22_3
    s_bitcmp1_b32 s32, 21
    s_cbranch_scc1 L_t22_1
    s_waitcnt vmcnt(2)
L_t22_1:
    s_bitcmp1_b32 s33, 21
    s_cbranch_scc1 L_t22_2
    s_waitcnt vmcnt(3)
L_t22_2:
    s_waitcnt vmcnt(4)
L_t22_3:
    s_bitcmp1_b32 s35, 21
    s_cbranch_scc1 L_t22_4
    s_waitcnt vmcnt(5)
L_t22_4:
    s_cbranch_vccz L_u22
    s_waitcnt vmcnt(6)
L_u22:
    buffer_load_dwordx4 v[60:63], v1, s[12:15], s64 offen offset:256 nt
    v_add_u32 v105, 1, v105
    ds_write_b32 v104, v105 offset:8192
    v_and_b32_dpp v20, v28, v8 row_newbcast:14 row_mask:0xf bank_mask:0xf
    v_and_b32_dpp v21, v28, v9 row_newbcast:14 row_mask:0xf bank_mask:0xf
    v_and_b32_dpp v22, v28, v10 row_newbcast:14 row_mask:0xf bank_mask:0xf
    v_and_b32_dpp v23, v28, v11 row_newbcast:14 row_mask:0xf bank_mask:0xf
    s_waitcnt vmcnt(15)
    v_mfma_f32_16x16x32_bf16 v[12:15], v[16:19], v[64:67], v[12:15]
    s_bitcmp1_b32 s34, 22
    s_cbranch_scc1 L_t23_3
    s_bitcmp1_b32 s32, 22
    s_cbranch_scc1 L_t23_1
    s_waitcnt vmcnt(2)
L_t23_1:
    s_bitcmp1_b32 s33, 22
    s_cbranch_scc1 L_t23_2
    s_waitcnt vmcnt(3)
L_t23_2:
    s_waitcnt vmcnt(4)
L_t23_3:
    s_bitcmp1_b32 s35, 22
    s_cbranch_scc1 L_t23_4
    s_waitcnt vmcnt(5)
L_t23_4:
    s_cbranch_vccz L_u23
    s_waitcnt vmcnt(6)
L_u23:
    buffer_load_dwordx4 v[64:67], v1, s[12:15], s64 offen offset:512 nt
    v_and_b32_dpp v16, v28, v8 row_newbcast:1 row_mask:0xf bank_mask:0xf
    v_and_b32_dpp v17, v28, v9 row_newbcast:1 row_mask:0xf bank_mask:0xf
    v_and_b32_dpp v18, v28, v10 row_newbcast:1 row_mask:0xf bank_mask:0xf
    v_and_b32_dpp v19, v28, v11 row_newbcast:1 row_mask:0xf bank_mask:0xf
    s_waitcnt vmcnt(15)
    v_mfma_f32_16x16x32_bf16 v[12:15], v[20:23], v[68:71], v[12:15]
    s_bitcmp1_b32 s34, 23
    s_cbranch_scc1 L_t24_3
    s_bitcmp1_b32 s32, 23
    s_cbranch_scc1 L_t24_1
    s_waitcnt vmcnt(2)
L_t24_1:
    s_bitcmp1_b32 s33, 23
    s_cbranch_scc1 L_t24_2
    s_waitcnt vmcnt(3)
L_t24_2:
    s_waitcnt vmcnt(4)
L_t24_3:
    s_bitcmp1_b32 s35, 23
    s_cbranch_scc1 L_t24_4
    s_waitcnt vmcnt(5)
L_t24_4:
    s_cbranch_vccz L_u24
    s_waitcnt vmcnt(6)
L_u24:
    buffer_load_dwordx4 v[68:71], v1, s[12:15], s64 offen offset:768 nt
    v_add_u32 v105, 1, v105
    ds_write_b32 v104, v105 offset:8192
    v_and_b32_dpp v20, v28, v8 row_newbcast:9 row_mask:0xf bank_mask:0xf
    v_and_b32_dpp v21, v28, v9 row_newbcast:9 row_mask:0xf bank_mask:0xf
    v_and_b32_dpp v22, v28, v10 row_newbcast:9 row_mask:0xf bank_mask:0xf
    v_and_b32_dpp v23, v28, v11 row_newbcast:9 row_mask:0xf bank_mask:0xf
    s_waitcnt vmcnt(15)
    v_mfma_f32_16x16x32_bf16 v[12:15], v[16:19], v[72:75], v[12:15]
    s_bitcmp1_b32 s34, 24
    s_cbranch_scc1 L_t25_3
    s_bitcmp1_b32 s32, 24
    s_cbranch_scc1 L_t25_1
    s_waitcnt vmcnt(2)
L_t25_1:
    s_bitcmp1_b32 s33, 24
    s_cbranch_scc1 L_t25_2
    s_waitcnt vmcnt(3)
L_t25_2:
    s_waitcnt vmcnt(4)
L_t25_3:
    s_bitcmp1_b32 s35, 24
    s_cbranch_scc1 L_t25_4
    s_waitcnt vmcnt(5)
L_t25_4:
    s_cbranch_vccz L_u25
    s_waitcnt vmcnt(6)
L_u25:
    buffer_load_dwordx4 v[72:75], v1, s[12:15], s65 offen nt
    s_cmp_lg_u32 s3, 0
    s_cbranch_scc1 L_notlast2
    s_waitcnt lgkmcnt(0)
    s_barrier
    v_and_b32 v26, 3, v0
    v_lshlrev_b32 v26, 3, v26
    ds_read_b64 v[32:33], v26 offset:2048
    s_waitcnt lgkmcnt(0)
    v_max_f32_dpp v25, v32, v32 quad_perm:[1,0,3,2] row_mask:0xf bank_mask:0xf
    s_nop 1
    v_max_f32_dpp v25, v25, v25 quad_perm:[2,3,0,1] row_mask:0xf bank_mask:0xf
    v_sub_f32 v32, v32, v25
    v_sub_f32 v108, v2, v25
    v_exp_f32 v32, v32
    v_exp_f32 v108, v108
    v_mul_f32 v32, v32, v33
    s_nop 1
    v_add_f32_dpp v32, v32, v32 quad_perm:[1,0,3,2] row_mask:0xf bank_mask:0xf
    s_nop 1
    v_add_f32_dpp v32, v32, v32 quad_perm:[2,3,0,1] row_mask:0xf bank_mask:0xf
    v_rcp_f32 v32, v32
    s_nop 0
    v_mul_f32 v108, v108, v32
L_notlast2:
    v_and_b32_dpp v16, v28, v8 row_newbcast:5 row_mask:0xf bank_mask:0xf
    v_and_b32_dpp v17, v28, v9 row_newbcast:5 row_mask:0xf bank_mask:0xf
    v_and_b32_dpp v18, v28, v10 row_newbcast:5 row_mask:0xf bank_mask:0xf
    v_and_b32_dpp v19, v28, v11 row_newbcast:5 row_mask:0xf bank_mask:0xf
    s_waitcnt vmcnt(15)
    v_mfma_f32_16x16x32_bf16 v[12:15], v[20:23], v[76:79], v[12:15]
    s_bitcmp1_b32 s34, 25
    s_cbranch_scc1 L_t26_3
    s_bitcmp1_b32 s32, 25
    s_cbranch_scc1 L_t26_1
    s_waitcnt vmcnt(2)
L_t26_1:
    s_bitcmp1_b32 s33, 25
    s_cbranch_scc1 L_t26_2
    s_waitcnt vmcnt(3)
L_t26_2:
    s_waitcnt vmcnt(4)
L_t26_3:
    s_bitcmp1_b32 s35, 25
    s_cbranch_scc1 L_t26_4
    s_waitcnt vmcnt(5)
L_t26_4:
    s_cbranch_vccz L_u26
    s_waitcnt vmcnt(6)
L_u26:
    buffer_load_dwordx4 v[76:79], v1, s[12:15], s65 offen offset:256 nt
    v_add_u32 v105, 1, v105
    ds_write_b32 v104, v105 offset:8192
    v_and_b32_dpp v20, v28, v8 row_newbcast:13 row_mask:0xf bank_mask:0xf
    v_and_b32_dpp v21, v28, v9 row_newbcast:13 row_mask:0xf bank_mask:0xf
    v_and_b32_dpp v22, v28, v10 row_newbcast:13 row_mask:0xf bank_mask:0xf
    v_and_b32_dpp v23, v28, v11 row_newbcast:13 row_mask:0xf bank_mask:0xf
    s_waitcnt vmcnt(15)
    v_mfma_f32_16x16x32_bf16 v[12:15], v[16:19], v[80:83], v[12:15]
    s_bitcmp1_b32 s34, 26
    s_cbranch_scc1 L_t27_3
    s_bitcmp1_b32 s32, 26
    s_cbranch_scc1 L_t27_1
    s_waitcnt vmcnt(2)
L_t27_1:
    s_bitcmp1_b32 s33, 26
    s_cbranch_scc1 L_t27_2
    s_waitcnt vmcnt(3)
L_t27_2:
    s_waitcnt vmcnt(4)
L_t27_3:
    s_bitcmp1_b32 s35, 26
    s_cbranch_scc1 L_t27_4
    s_waitcnt vmcnt(5)
L_t27_4:
    s_cbranch_vccz L_u27
    s_waitcnt vmcnt(6)
L_u27:
    buffer_load_dwordx4 v[80:83], v1, s[12:15], s65 offen offset:512 nt
    v_and_b32_dpp v16, v28, v8 row_newbcast:3 row_mask:0xf bank_mask:0xf
    v_and_b32_dpp v17, v28, v9 row_newbcast:3 row_mask:0xf bank_mask:0xf
    v_and_b32_dpp v18, v28, v10 row_newbcast:3 row_mask:0xf bank_mask:0xf
    v_and_b32_dpp v19, v28, v11 row_newbcast:3 row_mask:0xf bank_mask:0xf
    s_waitcnt vmcnt(15)
    v_mfma_f32_16x16x32_bf16 v[12:15], v[20:23], v[84:87], v[12:15]
    s_bitcmp1_b32 s34, 27
    s_cbranch_scc1 L_t28_3
    s_bitcmp1_b32 s32, 27
    s_cbranch_scc1 L_t28_1
    s_waitcnt vmcnt(2)
L_t28_1:
    s_bitcmp1_b32 s33, 27
    s_cbranch_scc1 L_t28_2
    s_waitcnt vmcnt(3)
L_t28_2:
    s_waitcnt vmcnt(4)
L_t28_3:
    s_bitcmp1_b32 s35, 27
    s_cbranch_scc1 L_t28_4
    s_waitcnt vmcnt(5)
L_t28_4:
    s_cbranch_vccz L_u28
    s_waitcnt vmcnt(6)
L_u28:
    buffer_load_dwordx4 v[84:87], v1, s[12:15], s65 offen offset:768 nt
    v_add_u32 v105, 1, v105
    ds_write_b32 v104, v105 offset:8192
    v_and_b32_dpp v20, v28, v8 row_newbcast:11 row_mask:0xf bank_mask:0xf
    v_and_b32_dpp v21, v28, v9 row_newbcast:11 row_mask:0xf bank_mask:0xf
    v_and_b32_dpp v22, v28, v10 row_newbcast:11 row_mask:0xf bank_mask:0xf
    v_and_b32_dpp v23, v28, v11 row_newbcast:11 row_mask:0xf bank_mask:0xf
    s_waitcnt vmcnt(15)
    v_mfma_f32_16x16x32_bf16 v[12:15], v[16:19], v[88:91], v[12:15]
    s_bitcmp1_b32 s34, 28
    s_cbranch_scc1 L_t29_3
    s_bitcmp1_b32 s32, 28
    s_cbranch_scc1 L_t29_1
    s_waitcnt vmcnt(2)
L_t29_1:
    s_bitcmp1_b32 s33, 28
    s_cbranch_scc1 L_t29_2
    s_waitcnt vmcnt(3)
L_t29_2:
    s_waitcnt vmcnt(4)
L_t29_3:
    s_bitcmp1_b32 s35, 28
    s_cbranch_scc1 L_t29_4
    s_waitcnt vmcnt(5)
L_t29_4:
    s_cbranch_vccz L_u29
    s_waitcnt vmcnt(6)
L_u29:
    buffer_load_dwordx4 v[88:91], v1, s[12:15], s66 offen nt
    v_and_b32_dpp v16, v28, v8 row_newbcast:7 row_mask:0xf bank_mask:0xf
    v_and_b32_dpp v17, v28, v9 row_newbcast:7 row_mask:0xf bank_mask:0xf
    v_and_b32_dpp v18, v28, v10 row_newbcast:7 row_mask:0xf bank_mask:0xf
    v_and_b32_dpp v19, v28, v11 row_newbcast:7 row_mask:0xf bank_mask:0xf
    s_waitcnt vmcnt(15)
    v_mfma_f32_16x16x32_bf16 v[12:15], v[20:23], v[92:95], v[12:15]
    s_bitcmp1_b32 s34, 29
    s_cbranch_scc1 L_t30_3
    s_bitcmp1_b32 s32, 29
    s_cbranch_scc1 L_t30_1
    s_waitcnt vmcnt(2)
L_t30_1:
    s_bitcmp1_b32 s33, 29
    s_cbranch_scc1 L_t30_2
    s_waitcnt vmcnt(3)
L_t30_2:
    s_waitcnt vmcnt(4)
L_t30_3:
    s_bitcmp1_b32 s35, 29
    s_cbranch_scc1 L_t30_4
    s_waitcnt vmcnt(5)
L_t30_4:
    s_cbranch_vccz L_u30
    s_waitcnt vmcnt(6)
L_u30:
    buffer_load_dwordx4 v[92:95], v1, s[12:15], s66 offen offset:256 nt
    v_add_u32 v105, 1, v105
    ds_write_b32 v104, v105 offset:8192
    v_and_b32_dpp v20, v28, v8 row_newbcast:15 row_mask:0xf bank_mask:0xf
    v_and_b32_dpp v21, v28, v9 row_newbcast:15 row_mask:0xf bank_mask:0xf
    v_and_b32_dpp v22, v28, v10 row_newbcast:15 row_mask:0xf bank_mask:0xf
    v_and_b32_dpp v23, v28, v11 row_newbcast:15 row_mask:0xf bank_mask:0xf
    s_waitcnt vmcnt(15)
    v_mfma_f32_16x16x32_bf16 v[12:15], v[16:19], v[96:99], v[12:15]
    s_bitcmp1_b32 s34, 30
    s_cbranch_scc1 L_t31_3
    s_bitcmp1_b32 s32, 30
    s_cbranch_scc1 L_t31_1
    s_waitcnt vmcnt(2)
L_t31_1:
    s_bitcmp1_b32 s33, 30
    s_cbranch_scc1 L_t31_2
    s_waitcnt vmcnt(3)
L_t31_2:
    s_waitcnt vmcnt(4)
L_t31_3:
    s_bitcmp1_b32 s35, 30
    s_cbranch_scc1 L_t31_4
    s_waitcnt vmcnt(5)
L_t31_4:
    s_cbranch_vccz L_u31
    s_waitcnt vmcnt(6)
L_u31:
    buffer_load_dwordx4 v[96:99], v1, s[12:15], s66 offen offset:512 nt
    s_waitcnt vmcnt(15)
    v_mfma_f32_16x16x32_bf16 v[12:15], v[20:23], v[100:103], v[12:15]
    s_cmp_eq_u32 s3, 0
    s_cbranch_scc1 L_fin
    ds_read_b128 v[112:115], v106 offset:9216
    s_bitcmp1_b32 s34, 31
    s_cbranch_scc1 L_t32_3
    s_bitcmp1_b32 s32, 31
    s_cbranch_scc1 L_t32_1
    s_waitcnt vmcnt(2)
L_t32_1:
    s_bitcmp1_b32 s33, 31
    s_cbranch_scc1 L_t32_2
    s_waitcnt vmcnt(3)
L_t32_2:
    s_waitcnt vmcnt(4)
L_t32_3:
    s_bitcmp1_b32 s35, 31
    s_cbranch_scc1 L_t32_4
    s_waitcnt vmcnt(5)
L_t32_4:
    s_cbranch_vccz L_u32
    s_waitcnt vmcnt(6)
L_u32:
    buffer_load_dwordx4 v[100:103], v1, s[12:15], s66 offen offset:768 nt
    v_add_u32 v105, 1, v105
    ds_write_b32 v104, v105 offset:8192
    s_branch L_vloop
L_fin:
    v_lshlrev_b32 v1, 3, v0
    s_mov_b32 exec_hi, 0
    s_nop 3
    v_mul_f32 v12, v12, v108
    v_mul_f32 v13, v13, v108
    v_mul_f32 v14, v14, v108
    v_mul_f32 v15, v15, v108
    ds_write_b128 v107, v[12:15]
    s_mov_b64 exec, -1
    s_waitcnt lgkmcnt(0)
    s_barrier
    s_cmp_lg_u32 s40, 0
    s_cbranch_scc1 L_end
    ds_read_b64 v[8:9], v1 offset:0
    ds_read_b64 v[10:11], v1 offset:512
    ds_read_b64 v[12:13], v1 offset:1024
    ds_read_b64 v[14:15], v1 offset:1536
    v_lshlrev_b32 v1, 2, v0
    s_waitcnt lgkmcnt(2)
    v_add_f32 v8, v8, v10
    v_add_f32 v9, v9, v11
    s_waitcnt lgkmcnt(1)
    v_add_f32 v8, v8, v12
    v_add_f32 v9, v9, v13
    s_waitcnt lgkmcnt(0)
    v_add_f32 v8, v8, v14
    v_add_f32 v9, v9, v15
    v_cvt_pk_bf16_f32 v6, v8, v9
    buffer_store_dword v6, v1, s[48:51], 0 offen
L_end:
    s_endpgm
L_helper:
    s_load_dwordx4 s[12:15], s[0:1], 32
    s_getreg_b32 s27, hwreg(HW_REG_XCC_ID)
    v_and_b32 v2, 63, v0
    s_and_b32 s27, s27, 7
    s_lshl_b32 s28, s27, 12
    s_add_u32 s29, s28, 0x40000
    s_lshl_b32 s28, s27, 2
    s_lshl_b32 s31, s2, 2
    s_lshl_b32 s32, s2, 12
    s_add_u32 s32, s32, 0x50000
    s_mov_b32 s33, 0
    v_lshlrev_b32 v23, 12, v2
    v_add_u32 v23, 0x50000, v23
    v_mov_b32 v24, s32
    v_lshlrev_b32 v13, 8, v2
    v_lshlrev_b32 v14, 2, v2
    v_mov_b32 v4, 0
    v_mov_b32 v25, 0
    v_mov_b32 v26, 0
    v_mov_b32 v12, 0
    s_mov_b32 s16, 0xffffffff
    v_writelane_b32 v12, s16, 0
    v_writelane_b32 v12, s16, 4
    v_writelane_b32 v12, s16, 8
    v_writelane_b32 v12, s16, 12
    s_mov_b32 s16, 0xffffffff
    v_writelane_b32 v12, s16, 1
    v_writelane_b32 v12, s16, 5
    v_writelane_b32 v12, s16, 9
    v_writelane_b32 v12, s16, 13
    s_mov_b32 s16, 0xaaaaaaaa
    v_writelane_b32 v12, s16, 2
    v_writelane_b32 v12, s16, 6
    v_writelane_b32 v12, s16, 10
    v_writelane_b32 v12, s16, 14
    s_mov_b32 s16, 0x0
    v_writelane_b32 v12, s16, 3
    v_writelane_b32 v12, s16, 7
    v_writelane_b32 v12, s16, 11
    v_writelane_b32 v12, s16, 15
    v_add_u32 v3, 1, v2
    v_mov_b32 v15, s29
    v_mov_b32 v20, s28
    v_mov_b32 v21, s31
    s_mov_b64 exec, 0xffff
    ds_write_b32 v14, v12 offset:9216
    s_mov_b64 exec, 0xf
    ds_write_b32 v13, v4 offset:8192
    s_mov_b32 s17, 168
    s_mov_b32 s18, 0
    s_mov_b32 s20, 0
    s_mov_b32 s21, 0
    s_mov_b32 s30, 0
    s_waitcnt lgkmcnt(0)
    s_cmp_lt_u32 s2, 8
    s_cselect_b32 s17, 184, s17
    s_cselect_b32 s19, 2, 2
    s_cbranch_scc1 L_linit
    s_barrier
L_fwait:
    s_sleep 4
    ds_read_b32 v6, v13 offset:8192
    s_waitcnt lgkmcnt(0)
    v_readfirstlane_b32 s22, v6
    s_nop 0
    s_cmp_ge_u32 s22, 240
    s_cbranch_scc1 L_hend
    s_lshr_b32 s23, s22, 3
    s_cmp_eq_u32 s23, s20
    s_cbranch_scc1 L_fwait
    s_mov_b32 s20, s23
    global_load_dword v18, v20, s[12:13] offset:128 sc1
    s_waitcnt vmcnt(0)
    v_readfirstlane_b32 s16, v18
    s_nop 0
    s_cmp_eq_u32 s16, 0
    s_cbranch_scc1 L_fwait
    s_branch L_poll
L_linit:
    s_mov_b64 exec, 1
    global_store_dword v15, v4, s[14:15]
    global_store_dword v24, v4, s[14:15] sc1
    v_mov_b32 v10, 1
    s_barrier
    s_waitcnt vmcnt(0)
    global_store_dword v20, v10, s[12:13] offset:128 sc1
    global_store_dword v21, v10, s[12:13] sc1
    s_mov_b64 exec, 0xf
L_poll:
    s_sleep 4
    s_cmp_lt_u32 s2, 8
    s_cbranch_scc1 L_lead
    global_load_dword v18, v15, s[14:15] sc1
    ds_read_b32 v6, v13 offset:8192
    s_waitcnt vmcnt(0) lgkmcnt(0)
    v_readfirstlane_b32 s16, v18
    v_readfirstlane_b32 s22, v6
    s_branch L_chk
L_lead:
    ds_read_b32 v6, v13 offset:8192
    s_waitcnt lgkmcnt(0)
    v_readfirstlane_b32 s22, v6
    s_nop 0
    s_lshr_b32 s23, s22, 1
    s_cmp_eq_u32 s23, s20
    s_cbranch_scc1 L_next
    s_mov_b32 s20, s23
    s_sub_u32 s16, s22, s21
    v_mov_b32 v10, s16
    s_mov_b64 exec, 1
    global_store_dword v15, v10, s[14:15]
    s_lshr_b32 s23, s22, 4
    s_cmp_eq_u32 s23, s30
    s_cbranch_scc1 L_nopub
    s_mov_b32 s30, s23
    s_lshl_b32 s23, s23, 4
    v_mov_b32 v11, s23
    global_store_dword v24, v11, s[14:15] sc1
L_nopub:
    s_cmp_eq_u32 s30, 0
    s_cbranch_scc1 L_noxch
    s_cmp_gt_u32 s22, 236
    s_cbranch_scc1 L_noxch
    s_mov_b64 exec, 0xff
    s_cmp_lg_u32 s33, 0
    s_cbranch_scc1 L_ready
    global_load_dword v22, v14, s[12:13] sc1
    s_waitcnt vmcnt(0)
    v_cmp_eq_u32 vcc, 0, v22
    s_nop 0
    s_cmp_lg_u64 vcc, 0
    s_cbranch_scc1 L_noxch
    s_mov_b32 s33, 1
L_ready:
    global_load_dword v22, v23, s[14:15] sc1
    s_waitcnt vmcnt(0)
    v_sub_u32 v27, s22, v22
    v_subrev_u32 v28, 16, v27
    v_max_i32 v28, v28, v26
    v_cmp_ne_u32 vcc, v22, v25
    s_nop 1
    v_cndmask_b32 v26, v28, v27, vcc
    v_mov_b32 v25, v22
    s_nop 0
    v_add_u32_dpp v27, v26, v26 quad_perm:[1,0,3,2] row_mask:0xf bank_mask:0xf
    s_nop 1
    v_add_u32_dpp v27, v27, v27 quad_perm:[2,3,0,1] row_mask:0xf bank_mask:0xf
    s_nop 1
    v_add_u32_dpp v27, v27, v27 row_half_mirror row_mask:0xf bank_mask:0xf
    v_readlane_b32 s25, v26, s2
    v_readfirstlane_b32 s24, v27
    s_lshl_b32 s25, s25, 3
    s_sub_u32 s24, s24, s25
    s_add_i32 s24, s24, 4
    s_ashr_i32 s21, s24, 3
L_noxch:
    s_mov_b64 exec, 0xf
L_chk:
    s_cmp_eq_u32 s16, s18
    s_cbranch_scc1 L_next
    s_mov_b32 s18, s16
    s_add_i32 s26, s16, s19
    v_subrev_u32 v16, s26, v6
    v_mul_i32_i24 v17, -4, v16
    v_add_u32 v17, s17, v17
    v_max_i32 v17, 96, v17
    v_min_i32 v17, 224, v17
    s_mov_b64 exec, -1
    v_readlane_b32 s26, v17, 0
    s_nop 1
    v_mul_u32_u24 v10, s26, v2
    v_mul_u32_u24 v11, s26, v3
    v_lshrrev_b32 v10, 5, v10
    v_lshrrev_b32 v11, 5, v11
    v_sub_u32 v10, v11, v10
    v_cmp_le_u32 s[34:35], 4, v10
    v_cmp_le_u32 s[36:37], 5, v10
    v_cmp_le_u32 s[38:39], 6, v10
    v_cmp_le_u32 s[40:41], 7, v10
    s_nop 0
    v_writelane_b32 v12, s34, 0
    v_writelane_b32 v12, s36, 1
    v_writelane_b32 v12, s38, 2
    v_writelane_b32 v12, s40, 3
    v_readlane_b32 s26, v17, 1
    s_nop 1
    v_mul_u32_u24 v10, s26, v2
    v_mul_u32_u24 v11, s26, v3
    v_lshrrev_b32 v10, 5, v10
    v_lshrrev_b32 v11, 5, v11
    v_sub_u32 v10, v11, v10
    v_cmp_le_u32 s[34:35], 4, v10
    v_cmp_le_u32 s[36:37], 5, v10
    v_cmp_le_u32 s[38:39], 6, v10
    v_cmp_le_u32 s[40:41], 7, v10
    s_nop 0
    v_writelane_b32 v12, s34, 4
    v_writelane_b32 v12, s36, 5
    v_writelane_b32 v12, s38, 6
    v_writelane_b32 v12, s40, 7
    v_readlane_b32 s26, v17, 2
    s_nop 1
    v_mul_u32_u24 v10, s26, v2
    v_mul_u32_u24 v11, s26, v3
    v_lshrrev_b32 v10, 5, v10
    v_lshrrev_b32 v11, 5, v11
    v_sub_u32 v10, v11, v10
    v_cmp_le_u32 s[34:35], 4, v10
    v_cmp_le_u32 s[36:37], 5, v10
    v_cmp_le_u32 s[38:39], 6, v10
    v_cmp_le_u32 s[40:41], 7, v10
    s_nop 0
    v_writelane_b32 v12, s34, 8
    v_writelane_b32 v12, s36, 9
    v_writelane_b32 v12, s38, 10
    v_writelane_b32 v12, s40, 11
    v_readlane_b32 s26, v17, 3
    s_nop 1
    v_mul_u32_u24 v10, s26, v2
    v_mul_u32_u24 v11, s26, v3
    v_lshrrev_b32 v10, 5, v10
    v_lshrrev_b32 v11, 5, v11
    v_sub_u32 v10, v11, v10
    v_cmp_le_u32 s[34:35], 4, v10
    v_cmp_le_u32 s[36:37], 5, v10
    v_cmp_le_u32 s[38:39], 6, v10
    v_cmp_le_u32 s[40:41], 7, v10
    s_nop 0
    v_writelane_b32 v12, s34, 12
    v_writelane_b32 v12, s36, 13
    v_writelane_b32 v12, s38, 14
    v_writelane_b32 v12, s40, 15
    s_mov_b64 exec, 0xffff
    ds_write_b32 v14, v12 offset:9216
    s_mov_b64 exec, 0xf
L_next:
    s_cmp_lt_u32 s22, 240
    s_cbranch_scc1 L_poll
L_hend:
    s_endpgm
.section .rodata,"a"
.p2align 6
.amdhsa_kernel standalone__softmax_full_bidir__sampling_kernel
  .amdhsa_next_free_vgpr 116
  .amdhsa_next_free_sgpr 67
  .amdhsa_accum_offset 116
  .amdhsa_group_segment_fixed_size 0
  .amdhsa_kernarg_size 48
  .amdhsa_user_sgpr_count 2
  .amdhsa_user_sgpr_kernarg_segment_ptr 1
  .amdhsa_system_sgpr_workgroup_id_x 1
.end_amdhsa_kernel
```
